```python
import torch

def _softmax(x, axis=-1):
    return torch.softmax(x, dim=axis)
def _gelu(x):
    return torch.nn.functional.gelu(x, approximate="tanh")
def _silu(x):
    return torch.nn.functional.silu(x)
def _sigmoid(x):
    return torch.sigmoid(x)
def _layernorm(x, axis=-1, eps=1e-5):
    m = x.mean(dim=axis, keepdim=True)
    v = x.var(dim=axis, keepdim=True, unbiased=False)
    return (x - m) / torch.sqrt(v + eps)
def _scatter_add(tgt, idx, src, axis=0):
    return tgt.clone().index_add_(axis, idx, src)
def _segment_sum(src, seg, n):
    out = torch.zeros((n,) + src.shape[1:], dtype=src.dtype)
    return out.index_add_(0, seg, src)
def _pad(x, pw):
    flat = tuple(v for pair in reversed(pw) for v in pair)
    return torch.nn.functional.pad(x, flat)

kernel_name = 'recurrent_scan__sliding_block_cached__mixer_channel_mlp__decode'

def setup_inputs():

    _w = (lambda a: (lambda t: t.to(torch.bfloat16) if t.is_floating_point() else t)(torch.as_tensor(a)))
    def _A_setup():
        B, Sq, D = 4, 1, 512
        Hq, Hkv, Sk, Dh = 32, 8, 4096, 128
        assert Hq % Hkv == 0, (Hq, Hkv)
        return {
            "x": _w((lambda *s: torch.randn(*s, dtype=torch.bfloat16) * 0.1)(B, Sq, D)),
            "k_cache": _w((lambda *s: torch.randn(*s, dtype=torch.bfloat16) * 0.8)(B, Hkv, Sk, Dh)),
            "v_cache": _w((lambda *s: torch.randn(*s, dtype=torch.bfloat16) * 3.2)(B, Hkv, Sk, Dh)),
            "wq": _w((lambda *s: torch.randn(*s, dtype=torch.bfloat16) * 0.8)(D, Hq * Dh) * (D ** -0.5)),
            "wo": _w((lambda *s: torch.randn(*s, dtype=torch.bfloat16) * 3.2)(Hq * Dh, D) * ((Hq * Dh) ** -0.5)),
        }
    _A_in = _A_setup()

    def _B_setup():
        B, S, D, F = 4, 1, 512, 1792
        return {
            "x": _w((lambda *s: torch.randn(*s, dtype=torch.bfloat16) * 0.1)(B, S, D)),
            "w1": _w((lambda *s: torch.randn(*s, dtype=torch.bfloat16) * 3.2)(D, F) * (D ** -0.5)),
            "b1": _w((lambda *s: torch.randn(*s, dtype=torch.bfloat16) * 3.2)(F)),
            "w2": _w((lambda *s: torch.randn(*s, dtype=torch.bfloat16) * 3.2)(F, D) * (F ** -0.5)),
            "b2": _w((lambda *s: torch.randn(*s, dtype=torch.bfloat16) * 3.2)(D)),
        }
    _B_in = _B_setup()

    return {
        "A_x": _A_in["x"],
        "A_k_cache": _A_in["k_cache"],
        "A_v_cache": _A_in["v_cache"],
        "A_wq": _A_in["wq"],
        "A_wo": _A_in["wo"],
        "B_x": _B_in["x"],
        "B_w1": _B_in["w1"],
        "B_b1": _B_in["b1"],
        "B_w2": _B_in["w2"],
        "B_b2": _B_in["b2"],
    }

def reference(A_x, A_k_cache, A_v_cache, A_wq, A_wo, B_x, B_w1, B_b1, B_w2, B_b2):
    def _A_ref(x, k_cache, v_cache, wq, wo):
        B, Sq, D = x.shape
        Hq, Dh = 32, 128
        Hkv, Sk = k_cache.shape[1], k_cache.shape[2]
        W = min(4096, max(256, Sk // 4))
        rep = Hq // Hkv
        q = (lambda x, *d: x.permute(*d))((x @ wq).reshape(B, Sq, Hq, Dh), 0, 2, 1, 3)
        k = (lambda x, n, axis: torch.repeat_interleave(x, n, dim=axis))(k_cache[:, :, Sk - W:, :], rep, axis=1)
        v = (lambda x, n, axis: torch.repeat_interleave(x, n, dim=axis))(v_cache[:, :, Sk - W:, :], rep, axis=1)
        scores = torch.einsum("bhqd,bhkd->bhqk", q, k) * (Dh ** -0.5)
        p = _softmax(scores, axis=-1)
        o = torch.einsum("bhqk,bhkd->bhqd", p, v)
        return (lambda x, *d: x.permute(*d))(o, 0, 2, 1, 3).reshape(B, Sq, Hq * Dh) @ wo

    def _B_ref(x, w1, b1, w2, b2):
        y = _layernorm(x, axis=-1)
        h = _gelu(torch.einsum("bsd,df->bsf", y, w1) + b1)
        return torch.einsum("bsf,fd->bsd", h, w2) + b2

    x = A_x
    xn = _layernorm(x, axis=-1)
    s = _A_ref(xn, A_k_cache, A_v_cache, A_wq, A_wo)
    g = _silu(_B_ref(xn, B_w1, B_b1, B_w2, B_b2))
    return x + s * g
```

```asm
; @launch grid=(256,1,1) block=(448,1,1) lds=138880
.amdgcn_target "amdgcn-amd-amdhsa--gfx950"
.text
.globl recurrent_scan__sliding_block_cached__mixer_channel_mlp__decode_kernel
.p2align 8
.type recurrent_scan__sliding_block_cached__mixer_channel_mlp__decode_kernel,@function
recurrent_scan__sliding_block_cached__mixer_channel_mlp__decode_kernel:
s_load_dwordx16 s[16:31], s[0:1], 0
s_load_dwordx8 s[32:39], s[0:1], 64
s_load_dwordx2 s[40:41], s[0:1], 96
s_lshr_b32 s4, s2, 3
s_cmp_ge_u32 s4, 32
s_cbranch_scc1 L_exit
v_lshrrev_b32 v2, 6, v0
v_bfe_u32 v4, v0, 3, 3
v_mov_b32 v8, 0
ds_write_b8 v0, v8
s_getpc_b64 s[8:9]
L_pc:
v_lshlrev_b32 v3, 7, v0
v_min_u32 v3, L_exit-L_pc, v3
global_load_dword v7, v3, s[8:9]
v_readfirstlane_b32 s7, v2
v_and_b32 v5, 6, v4
v_xor_b32 v5, v5, v0
v_and_b32 v5, 7, v5
v_lshlrev_b32 v5, 4, v5
s_and_b32 s3, s2, 7
s_cmp_eq_u32 s7, 6
s_cbranch_scc1 L_L
s_cmp_ge_u32 s7, 4
s_cbranch_scc1 L_PM
s_mov_b32 s51, 0x20000
v_lshlrev_b32 v11, 4, v0
s_lshr_b32 s10, s4, 3
s_lshl2_add_u32 s10, s10, s7
s_lshl_b32 s10, s10, 18
s_and_b32 s11, s4, 7
s_lshl3_add_u32 s11, s3, s11
s_xor_b32 s11, s11, 1
s_lshl_b32 s11, s11, 7
s_add_u32 s10, s10, s11
s_bfm_b32 s50, 1, 22
s_bfm_b32 s12, 6, 10
v_lshl_add_u32 v10, v4, 13, v5
s_lshl_b32 m0, s7, 12
s_addk_i32 m0, 2048
s_waitcnt lgkmcnt(0)
s_mov_b64 s[48:49], s[22:23]
global_load_dwordx4 v[12:15], v11, s[16:17]
buffer_load_dwordx4 v10, s[48:51], s10 offen offset:0 nt lds
s_add_u32 s10, s10, s12
buffer_load_dwordx4 v10, s[48:51], s10 offen offset:1024 nt lds
s_add_u32 s10, s10, s12
buffer_load_dwordx4 v10, s[48:51], s10 offen offset:2048 nt lds
s_add_u32 s10, s10, s12
buffer_load_dwordx4 v10, s[48:51], s10 offen offset:3072 nt lds
s_branch L_C
L_L:
s_barrier
v_and_b32 v1, 63, v0
s_lshr_b32 s5, s4, 3
s_and_b32 s6, s4, 7
s_mov_b32 s42, 2621440
s_mov_b32 s43, 0x20000
s_mov_b32 s46, 5000000
v_mov_b32 v6, 1
v_lshrrev_b32 v2, 4, v1
v_and_b32 v3, 15, v1
s_mul_i32 s10, s5, 6
s_add_u32 s10, s10, s3
s_cmp_gt_u32 s3, 0
s_cselect_b32 s11, 2, 0
s_sub_u32 s10, s10, s11
s_lshl_b32 s10, s10, 1
s_lshl2_add_u32 s11, s3, s5
s_add_u32 s11, s11, 48
s_bitcmp1_b32 3, s3
s_cselect_b32 s10, s11, s10
s_cselect_b32 s11, 64, 0
s_cselect_b32 s8, 30, 15
v_and_b32 v14, s11, v5
v_lshl_add_u32 v14, v14, 24, v5
v_mul_u32_u24 v32, 3584, v4
v_add_u32 v32, v32, v14
v_add_u32 v33, 27648, v32
v_add_u32 v34, 55296, v32
v_add_u32 v35, 82944, v32
v_xor_b32 v14, v3, v2
v_lshlrev_b32 v14, 4, v14
v_lshl_add_u32 v18, v2, 8, v14
v_xor_b32 v19, 64, v18
v_add_u32 v19, 7168, v19
v_xor_b32 v20, 128, v18
v_add_u32 v20, 14336, v20
v_xor_b32 v21, 192, v18
v_add_u32 v21, 21504, v21
s_mov_b32 s50, 1835008
s_mov_b32 s51, 0x20000
s_lshl_b32 s8, 1, s8
s_mul_i32 s12, s6, 229376
s_lshl_b32 s11, s10, 6
s_add_u32 s12, s12, s11
s_lshl_b32 s13, s5, 23
s_lshl_b32 s11, s3, 20
s_add_u32 s13, s13, s11
s_lshl_b32 s11, s6, 10
s_add_u32 s13, s13, s11
s_add_u32 s13, s13, 786432
s_bfm_b32 s54, 1, 25
s_mov_b32 s55, s51
s_mov_b32 s14, s13
s_waitcnt lgkmcnt(0)
s_mov_b32 s48, s28
s_mov_b32 s49, s29
s_mov_b32 m0, 18432
s_nop 0
buffer_load_dwordx4 v32, s[48:51], s12 offen offset:0 nt lds
buffer_load_dwordx4 v33, s[48:51], s12 offen offset:1024 nt lds
buffer_load_dwordx4 v34, s[48:51], s12 offen offset:2048 nt lds
buffer_load_dwordx4 v35, s[48:51], s12 offen offset:3072 nt lds
s_mov_b32 m0, 22528
s_add_u32 s12, s12, 114688
buffer_load_dwordx4 v32, s[48:51], s12 offen offset:0 nt lds
buffer_load_dwordx4 v33, s[48:51], s12 offen offset:1024 nt lds
buffer_load_dwordx4 v34, s[48:51], s12 offen offset:2048 nt lds
buffer_load_dwordx4 v35, s[48:51], s12 offen offset:3072 nt lds
s_mov_b32 s52, s18
s_mov_b32 s53, s19
s_mov_b32 m0, 26624
s_nop 0
buffer_load_dwordx4 v18, s[52:55], s13 offen offset:0 nt lds
buffer_load_dwordx4 v19, s[52:55], s13 offen offset:1024 nt lds
buffer_load_dwordx4 v20, s[52:55], s13 offen offset:2048 nt lds
buffer_load_dwordx4 v21, s[52:55], s13 offen offset:3072 nt lds
s_mov_b32 m0, 30720
s_add_u32 s13, s13, 32768
buffer_load_dwordx4 v18, s[52:55], s13 offen offset:0 nt lds
buffer_load_dwordx4 v19, s[52:55], s13 offen offset:1024 nt lds
buffer_load_dwordx4 v20, s[52:55], s13 offen offset:2048 nt lds
buffer_load_dwordx4 v21, s[52:55], s13 offen offset:3072 nt lds
s_mov_b32 m0, 34816
s_add_u32 s13, s13, 32768
buffer_load_dwordx4 v18, s[52:55], s13 offen offset:0 nt lds
buffer_load_dwordx4 v19, s[52:55], s13 offen offset:1024 nt lds
buffer_load_dwordx4 v20, s[52:55], s13 offen offset:2048 nt lds
buffer_load_dwordx4 v21, s[52:55], s13 offen offset:3072 nt lds
v_lshlrev_b32 v14, 1, v2
v_xor_b32 v14, v3, v14
v_lshlrev_b32 v14, 4, v14
v_lshl_add_u32 v22, v2, 8, v14
v_xor_b32 v23, 128, v22
v_add_u32 v24, 14336, v22
v_add_u32 v25, 21504, v23
v_add_u32 v23, 7168, v23
v_lshl_add_u32 v26, v4, 10, v5
v_add_u32 v27, 7168, v26
v_add_u32 v28, 14336, v26
v_add_u32 v29, 21504, v26
s_mov_b32 s58, s54
s_mov_b32 s59, s51
s_mov_b32 s62, 1835008
s_mov_b32 s63, s51
s_bfm_b32 s98, 1, 22
s_mov_b32 s99, s51
s_mov_b32 s56, s20
s_mov_b32 s57, s21
s_mov_b32 s60, s32
s_mov_b32 s61, s33
s_mov_b32 s96, s24
s_mov_b32 s97, s25
s_add_u32 s11, s6, 2
s_and_b32 s11, s11, 7
s_lshl_b32 s11, s11, 7
s_lshl_b32 s15, s10, 15
s_add_u32 s15, s15, s11
s_lshl2_add_u32 s9, s3, s5
s_lshl_b32 s9, s9, 17
s_lshl_b32 s11, s6, 7
s_add_u32 s9, s9, s11
s_mov_b32 m0, 38912
s_add_u32 s13, s13, 32768
s_waitcnt vmcnt(16)
buffer_load_dwordx4 v18, s[52:55], s13 offen offset:0 nt lds
buffer_load_dwordx4 v19, s[52:55], s13 offen offset:1024 nt lds
buffer_load_dwordx4 v20, s[52:55], s13 offen offset:2048 nt lds
buffer_load_dwordx4 v21, s[52:55], s13 offen offset:3072 nt lds
s_mov_b32 m0, 43008
s_add_u32 s13, s13, 32768
s_waitcnt vmcnt(16)
v_mov_b32 v30, 2
ds_write_b32 v8, v30 offset:4
buffer_load_dwordx4 v18, s[52:55], s13 offen offset:0 nt lds
buffer_load_dwordx4 v19, s[52:55], s13 offen offset:1024 nt lds
buffer_load_dwordx4 v20, s[52:55], s13 offen offset:2048 nt lds
buffer_load_dwordx4 v21, s[52:55], s13 offen offset:3072 nt lds
s_mov_b32 m0, 47104
s_add_u32 s13, s13, 32768
s_waitcnt vmcnt(16)
buffer_load_dwordx4 v18, s[52:55], s13 offen offset:0 nt lds
buffer_load_dwordx4 v19, s[52:55], s13 offen offset:1024 nt lds
buffer_load_dwordx4 v20, s[52:55], s13 offen offset:2048 nt lds
buffer_load_dwordx4 v21, s[52:55], s13 offen offset:3072 nt lds
s_mov_b32 m0, 59392
s_waitcnt vmcnt(16)
v_mov_b32 v30, 4
ds_write_b32 v8, v30 offset:4
buffer_load_dwordx4 v26, s[60:63], s15 offen offset:0 nt lds
buffer_load_dwordx4 v27, s[60:63], s15 offen offset:1024 nt lds
buffer_load_dwordx4 v28, s[60:63], s15 offen offset:2048 nt lds
buffer_load_dwordx4 v29, s[60:63], s15 offen offset:3072 nt lds
s_mov_b32 m0, 63488
s_add_u32 s15, s15, s8
s_waitcnt vmcnt(16)
buffer_load_dwordx4 v26, s[60:63], s15 offen offset:0 nt lds
buffer_load_dwordx4 v27, s[60:63], s15 offen offset:1024 nt lds
buffer_load_dwordx4 v28, s[60:63], s15 offen offset:2048 nt lds
buffer_load_dwordx4 v29, s[60:63], s15 offen offset:3072 nt lds
s_mov_b32 m0, 51200
s_add_u32 s13, s13, 32768
s_waitcnt vmcnt(16)
v_mov_b32 v30, 6
ds_write_b32 v8, v30 offset:4
buffer_load_dwordx4 v18, s[52:55], s13 offen offset:0 nt lds
buffer_load_dwordx4 v19, s[52:55], s13 offen offset:1024 nt lds
buffer_load_dwordx4 v20, s[52:55], s13 offen offset:2048 nt lds
buffer_load_dwordx4 v21, s[52:55], s13 offen offset:3072 nt lds
s_mov_b32 m0, 55296
s_add_u32 s13, s13, 32768
s_waitcnt vmcnt(16)
buffer_load_dwordx4 v18, s[52:55], s13 offen offset:0 nt lds
buffer_load_dwordx4 v19, s[52:55], s13 offen offset:1024 nt lds
buffer_load_dwordx4 v20, s[52:55], s13 offen offset:2048 nt lds
buffer_load_dwordx4 v21, s[52:55], s13 offen offset:3072 nt lds
s_mov_b32 m0, 67584
s_waitcnt vmcnt(16)
v_mov_b32 v30, 8
ds_write_b32 v8, v30 offset:4
buffer_load_dwordx4 v22, s[56:59], s14 offen offset:0 nt lds
buffer_load_dwordx4 v23, s[56:59], s14 offen offset:1024 nt lds
buffer_load_dwordx4 v24, s[56:59], s14 offen offset:2048 nt lds
buffer_load_dwordx4 v25, s[56:59], s14 offen offset:3072 nt lds
s_mov_b32 m0, 71680
s_add_u32 s14, s14, 32768
s_waitcnt vmcnt(16)
buffer_load_dwordx4 v22, s[56:59], s14 offen offset:0 nt lds
buffer_load_dwordx4 v23, s[56:59], s14 offen offset:1024 nt lds
buffer_load_dwordx4 v24, s[56:59], s14 offen offset:2048 nt lds
buffer_load_dwordx4 v25, s[56:59], s14 offen offset:3072 nt lds
s_mov_b32 m0, 75776
s_add_u32 s14, s14, 32768
s_waitcnt vmcnt(16)
v_mov_b32 v30, 10
ds_write_b32 v8, v30 offset:4
buffer_load_dwordx4 v22, s[56:59], s14 offen offset:0 nt lds
buffer_load_dwordx4 v23, s[56:59], s14 offen offset:1024 nt lds
buffer_load_dwordx4 v24, s[56:59], s14 offen offset:2048 nt lds
buffer_load_dwordx4 v25, s[56:59], s14 offen offset:3072 nt lds
s_mov_b32 m0, 79872
s_add_u32 s14, s14, 32768
s_waitcnt vmcnt(16)
buffer_load_dwordx4 v22, s[56:59], s14 offen offset:0 nt lds
buffer_load_dwordx4 v23, s[56:59], s14 offen offset:1024 nt lds
buffer_load_dwordx4 v24, s[56:59], s14 offen offset:2048 nt lds
buffer_load_dwordx4 v25, s[56:59], s14 offen offset:3072 nt lds
s_mov_b32 m0, 83968
s_add_u32 s14, s14, 32768
s_waitcnt vmcnt(16)
v_mov_b32 v30, 12
ds_write_b32 v8, v30 offset:4
buffer_load_dwordx4 v22, s[56:59], s14 offen offset:0 nt lds
buffer_load_dwordx4 v23, s[56:59], s14 offen offset:1024 nt lds
buffer_load_dwordx4 v24, s[56:59], s14 offen offset:2048 nt lds
buffer_load_dwordx4 v25, s[56:59], s14 offen offset:3072 nt lds
s_mov_b32 m0, 88064
s_add_u32 s14, s14, 32768
s_waitcnt vmcnt(16)
buffer_load_dwordx4 v22, s[56:59], s14 offen offset:0 nt lds
buffer_load_dwordx4 v23, s[56:59], s14 offen offset:1024 nt lds
buffer_load_dwordx4 v24, s[56:59], s14 offen offset:2048 nt lds
buffer_load_dwordx4 v25, s[56:59], s14 offen offset:3072 nt lds
s_mov_b32 m0, 92160
s_add_u32 s14, s14, 32768
s_waitcnt vmcnt(16)
v_mov_b32 v30, 14
ds_write_b32 v8, v30 offset:4
buffer_load_dwordx4 v22, s[56:59], s14 offen offset:0 nt lds
buffer_load_dwordx4 v23, s[56:59], s14 offen offset:1024 nt lds
buffer_load_dwordx4 v24, s[56:59], s14 offen offset:2048 nt lds
buffer_load_dwordx4 v25, s[56:59], s14 offen offset:3072 nt lds
s_mov_b32 m0, 96256
s_add_u32 s14, s14, 32768
s_waitcnt vmcnt(16)
buffer_load_dwordx4 v22, s[56:59], s14 offen offset:0 nt lds
buffer_load_dwordx4 v23, s[56:59], s14 offen offset:1024 nt lds
buffer_load_dwordx4 v24, s[56:59], s14 offen offset:2048 nt lds
buffer_load_dwordx4 v25, s[56:59], s14 offen offset:3072 nt lds
s_mov_b32 m0, 100352
s_waitcnt vmcnt(16)
v_mov_b32 v30, 16
ds_write_b32 v8, v30 offset:4
buffer_load_dwordx4 v26, s[96:99], s9 offen offset:0 nt lds
buffer_load_dwordx4 v27, s[96:99], s9 offen offset:1024 nt lds
buffer_load_dwordx4 v28, s[96:99], s9 offen offset:2048 nt lds
buffer_load_dwordx4 v29, s[96:99], s9 offen offset:3072 nt lds
s_mov_b32 m0, 104448
s_add_u32 s9, s9, 32768
s_waitcnt vmcnt(16)
buffer_load_dwordx4 v26, s[96:99], s9 offen offset:0 nt lds
buffer_load_dwordx4 v27, s[96:99], s9 offen offset:1024 nt lds
buffer_load_dwordx4 v28, s[96:99], s9 offen offset:2048 nt lds
buffer_load_dwordx4 v29, s[96:99], s9 offen offset:3072 nt lds
s_mov_b32 m0, 108544
s_add_u32 s9, s9, 32768
s_waitcnt vmcnt(16)
v_mov_b32 v30, 18
ds_write_b32 v8, v30 offset:4
buffer_load_dwordx4 v26, s[96:99], s9 offen offset:0 nt lds
buffer_load_dwordx4 v27, s[96:99], s9 offen offset:1024 nt lds
buffer_load_dwordx4 v28, s[96:99], s9 offen offset:2048 nt lds
buffer_load_dwordx4 v29, s[96:99], s9 offen offset:3072 nt lds
s_mov_b32 m0, 112640
s_add_u32 s9, s9, 32768
s_waitcnt vmcnt(16)
buffer_load_dwordx4 v26, s[96:99], s9 offen offset:0 nt lds
buffer_load_dwordx4 v27, s[96:99], s9 offen offset:1024 nt lds
buffer_load_dwordx4 v28, s[96:99], s9 offen offset:2048 nt lds
buffer_load_dwordx4 v29, s[96:99], s9 offen offset:3072 nt lds
v_mov_b32 v30, 20
s_waitcnt vmcnt(16)
ds_write_b32 v8, v30 offset:4
v_mov_b32 v30, 23
s_waitcnt vmcnt(4)
ds_write_b32 v8, v30 offset:4
s_waitcnt vmcnt(0)
s_barrier
s_branch L_end
L_PM:
s_barrier
v_and_b32 v1, 63, v0
s_lshr_b32 s5, s4, 3
s_and_b32 s6, s4, 7
s_mov_b32 s42, 2621440
s_mov_b32 s43, 0x20000
s_mov_b32 s46, 5000000
v_mov_b32 v6, 1
v_lshrrev_b32 v2, 4, v1
v_and_b32 v3, 15, v1
s_xor_b32 s9, s7, s4
s_and_b32 s9, s9, 1
s_lshr_b32 s10, s2, 6
s_lshl1_add_u32 s10, s10, s9
s_lshl_b32 s10, s10, 6
s_and_b32 s11, s2, 63
s_add_u32 s10, s10, s11
s_lshl_b32 s10, s10, 7
s_add_u32 s10, s10, 1900544
s_waitcnt lgkmcnt(0)
s_sleep 2
s_memtime s[12:13]
s_load_dword s11, s[40:41], s10
s_waitcnt lgkmcnt(0)
s_memtime s[14:15]
s_lshl_b32 s10, s9, 2
v_mov_b32 v10, s10
s_waitcnt lgkmcnt(0)
s_sub_u32 s12, s14, s12
v_mov_b32 v11, s12
ds_write_b32 v10, v11 offset:40
s_cmp_eq_u32 s7, 4
s_cbranch_scc1 L_P
s_branch L_M
L_C:
s_load_dword s44, s[40:41], 0
s_lshl_b32 s10, s3, 5
s_add_u32 s10, s10, s4
s_lshl1_add_u32 s11, s10, s7
s_lshl2_add_u32 s10, s10, s7
s_lshl_b32 s10, s10, 8
s_add_u32 s10, s10, 544768
s_lshl_b32 s11, s11, 4
s_add_u32 s11, s11, 528384
v_and_b32 v16, 15, v0
v_lshl_add_u32 v16, v16, 4, s10
v_writelane_b32 v16, s11, 16
v_mov_b32 v20, -1
v_mov_b32 v21, -1
v_mov_b32 v22, -1
v_mov_b32 v23, -1
s_cmp_lt_u32 s7, 2
s_cselect_b32 s10, 17, 16
s_bfm_b64 exec, s10, 0
global_store_dwordx4 v16, v[20:23], s[40:41]
s_mov_b64 exec, -1
s_barrier
s_setprio 2
v_and_b32 v1, 63, v0
s_lshr_b32 s5, s4, 3
s_and_b32 s6, s4, 7
s_mov_b32 s42, 2621440
s_mov_b32 s43, 0x20000
s_mov_b32 s46, 5000000
v_mov_b32 v6, 1
v_lshrrev_b32 v2, 4, v1
v_and_b32 v3, 15, v1
v_bfe_u32 v4, v1, 2, 2
v_and_b32 v5, 3, v1
s_mul_i32 s11, s7, 1088
s_add_u32 s11, s11, 116736
v_lshrrev_b32 v10, 2, v1
v_lshlrev_b32 v10, 6, v10
v_and_b32 v11, 1, v1
v_lshl_add_u32 v10, v11, 5, v10
v_and_b32 v11, 2, v1
v_lshl_add_u32 v10, v11, 2, v10
v_add_u32 v11, s11, v10
s_mov_b32 s55, 0xffff0000
v_lshl_add_u32 v27, v2, 2, v4
v_bfe_u32 v96, v27, 1, 2
v_lshlrev_b32 v96, 5, v96
v_lshl_add_u32 v96, v27, 7, v96
v_lshl_add_u32 v96, v5, 3, v96
s_lshl_b32 s12, s7, 5
v_xor_b32 v10, s12, v96
s_getreg_b32 s45, hwreg(HW_REG_XCC_ID, 0, 4)
v_mul_u32_u24 v24, 1088, v5
v_lshl_add_u32 v24, v2, 4, v24
s_lshl_b32 s10, s5, 8
s_add_u32 s10, s10, 116736
v_add_u32 v25, s10, v24
s_lshl_b32 s10, s6, 7
s_add_u32 s10, s10, 121088
v_add_u32 v24, s10, v24
s_lshl_b32 s14, s3, 15
s_lshl1_add_u32 s14, s12, s14
s_lshl_b32 s13, s4, 8
s_xor_b32 s58, s13, 256
s_add_u32 s58, s14, s58
s_add_u32 s58, s58, 4096
s_lshl2_add_u32 s59, s13, s14
s_add_u32 s59, s59, 266240
v_lshlrev_b32 v106, 13, v3
v_lshl_add_u32 v106, v2, 4, v106
v_lshlrev_b32 v107, 4, v1
v_mov_b32 v30, 384
v_sub_u32 v31, 0, v30
s_mov_b32 s50, 0x07060503
s_mov_b32 s51, 0x07060502
s_mov_b32 s52, 0x07060501
s_mov_b32 s13, 1
s_waitcnt vmcnt(5)
L_ln:
v_lshlrev_b32 v16, 16, v12
v_and_b32 v17, s55, v12
v_lshlrev_b32 v18, 16, v13
v_and_b32 v19, s55, v13
v_lshlrev_b32 v20, 16, v14
v_and_b32 v21, s55, v14
v_lshlrev_b32 v22, 16, v15
v_and_b32 v23, s55, v15
v_pk_add_f32 v[32:33], v[16:17], v[18:19]
v_pk_add_f32 v[34:35], v[20:21], v[22:23]
v_pk_add_f32 v[32:33], v[32:33], v[34:35]
v_add_f32 v32, v32, v33
s_nop 1
v_add_f32_dpp v32, v32, v32 quad_perm:[1,0,3,2] row_mask:0xf bank_mask:0xf
s_nop 1
v_add_f32_dpp v32, v32, v32 quad_perm:[2,3,0,1] row_mask:0xf bank_mask:0xf
s_nop 1
v_add_f32_dpp v32, v32, v32 row_half_mirror row_mask:0xf bank_mask:0xf
s_nop 1
v_add_f32_dpp v32, v32, v32 row_mirror row_mask:0xf bank_mask:0xf
s_nop 1
v_add_f32_dpp v32, v32, v32 row_bcast:15 row_mask:0xa bank_mask:0xf
s_nop 1
v_add_f32_dpp v32, v32, v32 row_bcast:31 row_mask:0xc bank_mask:0xf
s_nop 0
v_readlane_b32 s10, v32, 63
v_mov_b32 v15, 0x3b000000
s_nop 0
v_mul_f32 v12, s10, v15
v_pk_add_f32 v[32:33], v[16:17], v[12:13] op_sel_hi:[1,0] neg_lo:[0,1] neg_hi:[0,1]
v_pk_add_f32 v[34:35], v[18:19], v[12:13] op_sel_hi:[1,0] neg_lo:[0,1] neg_hi:[0,1]
v_pk_add_f32 v[36:37], v[20:21], v[12:13] op_sel_hi:[1,0] neg_lo:[0,1] neg_hi:[0,1]
v_pk_add_f32 v[38:39], v[22:23], v[12:13] op_sel_hi:[1,0] neg_lo:[0,1] neg_hi:[0,1]
v_pk_mul_f32 v[32:33], v[32:33], v[32:33]
v_pk_fma_f32 v[32:33], v[34:35], v[34:35], v[32:33]
v_pk_fma_f32 v[32:33], v[36:37], v[36:37], v[32:33]
v_pk_fma_f32 v[32:33], v[38:39], v[38:39], v[32:33]
v_add_f32 v32, v32, v33
v_cvt_pk_bf16_f32 v12, v12, v12
v_lshlrev_b32 v12, 16, v12
v_add_f32_dpp v32, v32, v32 quad_perm:[1,0,3,2] row_mask:0xf bank_mask:0xf
v_pk_add_f32 v[16:17], v[16:17], v[12:13] op_sel_hi:[1,0] neg_lo:[0,1] neg_hi:[0,1]
v_pk_add_f32 v[18:19], v[18:19], v[12:13] op_sel_hi:[1,0] neg_lo:[0,1] neg_hi:[0,1]
v_add_f32_dpp v32, v32, v32 quad_perm:[2,3,0,1] row_mask:0xf bank_mask:0xf
v_pk_add_f32 v[20:21], v[20:21], v[12:13] op_sel_hi:[1,0] neg_lo:[0,1] neg_hi:[0,1]
v_pk_add_f32 v[22:23], v[22:23], v[12:13] op_sel_hi:[1,0] neg_lo:[0,1] neg_hi:[0,1]
v_add_f32_dpp v32, v32, v32 row_half_mirror row_mask:0xf bank_mask:0xf
v_cvt_pk_bf16_f32 v34, v16, v17
v_cvt_pk_bf16_f32 v35, v18, v19
v_add_f32_dpp v32, v32, v32 row_mirror row_mask:0xf bank_mask:0xf
v_cvt_pk_bf16_f32 v36, v20, v21
v_cvt_pk_bf16_f32 v37, v22, v23
v_add_f32_dpp v32, v32, v32 row_bcast:15 row_mask:0xa bank_mask:0xf
v_lshlrev_b32 v16, 16, v34
v_and_b32 v17, s55, v34
v_add_f32_dpp v32, v32, v32 row_bcast:31 row_mask:0xc bank_mask:0xf
v_lshlrev_b32 v18, 16, v35
v_and_b32 v19, s55, v35
v_readlane_b32 s10, v32, 63
v_lshlrev_b32 v20, 16, v36
v_and_b32 v21, s55, v36
v_mul_f32 v12, s10, v15
v_cvt_pk_bf16_f32 v12, v12, v12
v_lshlrev_b32 v12, 16, v12
v_add_f32 v12, 0x3727c5ac, v12
v_cvt_pk_bf16_f32 v12, v12, v12
v_lshlrev_b32 v12, 16, v12
v_sqrt_f32 v12, v12
v_lshlrev_b32 v22, 16, v37
v_cvt_pk_bf16_f32 v12, v12, v12
v_lshlrev_b32 v12, 16, v12
v_rcp_f32 v12, v12
v_and_b32 v23, s55, v37
v_pk_mul_f32 v[16:17], v[16:17], v[12:13] op_sel_hi:[1,0]
v_pk_mul_f32 v[18:19], v[18:19], v[12:13] op_sel_hi:[1,0]
v_pk_mul_f32 v[20:21], v[20:21], v[12:13] op_sel_hi:[1,0]
v_pk_mul_f32 v[22:23], v[22:23], v[12:13] op_sel_hi:[1,0]
v_cvt_pk_bf16_f32 v12, v16, v17
v_cvt_pk_bf16_f32 v13, v18, v19
v_cvt_pk_bf16_f32 v14, v20, v21
v_cvt_pk_bf16_f32 v15, v22, v23
ds_write2_b64 v11, v[12:13], v[14:15] offset1:2
v_add_u32 v11, 4352, v11
s_sub_u32 s13, s13, 1
s_cbranch_scc0 L_ln
s_waitcnt vmcnt(0) lgkmcnt(0)
s_mov_b64 exec, 1
ds_add_u32 v8, v6 offset:0
s_mov_b64 exec, -1
s_mul_i32 s44, s44, 0x2c9277b5
s_add_u32 s44, s44, 0xac564b05
v_mov_b32 v111, s44
v_mov_b32 v115, s44
ds_write_b32 v8, v111 offset:52
W_1:
ds_read_b32 v9, v8 offset:0
ds_read_b64 v[28:29], v8 offset:40
ds_read_b128 v[64:67], v25 offset:0
ds_read_b64_tr_b16 v[40:41], v10 offset:2048
ds_read_b64_tr_b16 v[42:43], v10 offset:4096
ds_read_b128 v[68:71], v25 offset:64
ds_read_b64_tr_b16 v[44:45], v10 offset:6144
ds_read_b64_tr_b16 v[46:47], v10 offset:8192
ds_read_b128 v[72:75], v25 offset:128
ds_read_b64_tr_b16 v[48:49], v10 offset:10240
ds_read_b64_tr_b16 v[50:51], v10 offset:12288
ds_read_b128 v[76:79], v25 offset:192
ds_read_b64_tr_b16 v[52:53], v10 offset:14336
ds_read_b64_tr_b16 v[54:55], v10 offset:16384
s_sub_u32 s46, s46, 1
s_cbranch_scc1 L_end
s_waitcnt lgkmcnt(13)
v_cmp_gt_u32 vcc, 4, v9
s_cbranch_vccnz W_1
s_waitcnt lgkmcnt(9)
v_mfma_f32_16x16x32_bf16 v[16:19], v[40:43], v[64:67], 0
v_sub_u32 v110, v28, v29
v_min_u32 v28, v28, v29
s_waitcnt lgkmcnt(6)
v_mfma_f32_16x16x32_bf16 v[16:19], v[44:47], v[68:71], v[16:19]
v_cmp_ne_u32 vcc, 0, v28
v_med3_i32 v110, v110, v30, v31
s_waitcnt lgkmcnt(3)
v_mfma_f32_16x16x32_bf16 v[16:19], v[48:51], v[72:75], v[16:19]
v_sub_u32 v29, 0, v110
v_cndmask_b32 v110, v29, v110, vcc
v_lshl_or_b32 v110, v110, 4, s45
s_waitcnt lgkmcnt(0)
v_mfma_f32_16x16x32_bf16 v[16:19], v[52:55], v[76:79], v[16:19]
ds_read_b128 v[80:83], v24 offset:0
ds_read_b128 v[84:87], v24 offset:64
s_mov_b32 exec_lo, 0x000f000f
s_mov_b32 exec_hi, 0x000f000f
s_nop 3
v_cvt_pk_bf16_f32 v108, v16, v17
v_cvt_pk_bf16_f32 v109, v18, v19
buffer_store_dwordx4 v[108:111], v106, s[40:43], s58 offen
s_mov_b64 exec, 1
ds_add_u32 v8, v6 offset:28
s_mov_b64 exec, -1
s_branch W_3
W_2:
s_sleep 1
W_3:
ds_read_b32 v9, v8 offset:4
ds_read_b64_tr_b16 v[40:41], v10 offset:18432
ds_read_b64_tr_b16 v[42:43], v10 offset:20480
ds_read_b64_tr_b16 v[44:45], v10 offset:22528
ds_read_b64_tr_b16 v[46:47], v10 offset:24576
s_sub_u32 s46, s46, 1
s_cbranch_scc1 L_end
s_waitcnt lgkmcnt(4)
v_cmp_gt_u32 vcc, 2, v9
s_cbranch_vccnz W_2
s_waitcnt lgkmcnt(2)
v_mfma_f32_16x16x32_bf16 v[16:19], v[40:43], v[80:83], 0
s_waitcnt lgkmcnt(0)
v_mfma_f32_16x16x32_bf16 v[16:19], v[44:47], v[84:87], v[16:19]
s_mov_b32 exec_lo, 0x000f000f
s_mov_b32 exec_hi, 0x000f000f
s_nop 5
v_perm_b32 v112, v16, v19, s50
v_perm_b32 v113, v17, v19, s51
v_perm_b32 v114, v18, v19, s52
buffer_store_dwordx4 v[112:115], v107, s[40:43], s59 offen
s_mov_b64 exec, -1
s_lshl_b32 s10, s7, 13
s_add_u32 s10, s10, 26624
v_xor_b32 v10, v2, v3
v_lshlrev_b32 v10, 4, v10
v_lshl_add_u32 v10, v3, 8, v10
v_add_u32 v102, 125440, v10
v_add_u32 v10, s10, v10
v_xor_b32 v103, 64, v102
v_xor_b32 v104, 128, v102
v_xor_b32 v105, 192, v102
v_xor_b32 v11, 64, v10
v_xor_b32 v12, 128, v10
v_xor_b32 v13, 192, v10
s_lshl_b32 s10, s7, 2
s_add_u32 s10, s10, 128
v_lshlrev_b32 v15, 4, v5
v_add_u32 v24, s10, v15
v_add_u32 v15, 128, v15
s_add_u32 s10, s10, 64
v_mov_b32 v14, s10
s_lshl_b32 s10, s7, 10
s_add_u32 s10, s10, 129536
v_lshlrev_b32 v25, 4, v1
v_add_u32 v26, s10, v25
v_add_u32 v25, 129536, v25
v_and_b32 v28, 7, v27
s_lshl_b32 s10, s7, 1
v_xor_b32 v28, s10, v28
v_lshlrev_b32 v28, 5, v28
v_lshl_add_u32 v28, v27, 8, v28
v_lshl_add_u32 v28, v5, 3, v28
v_add_u32 v28, 67584, v28
v_xor_b32 v29, 32, v28
s_lshr_b32 s10, s7, 1
s_lshl_b32 s11, s10, 13
s_add_u32 s11, s11, 100352
v_add_u32 v96, s11, v96
v_xor_b32 v97, 32, v96
v_xor_b32 v98, 64, v96
v_xor_b32 v99, 96, v96
v_lshlrev_b32 v30, 14, v3
v_lshl_add_u32 v30, v2, 8, v30
s_lshl_b32 s14, s3, 16
s_add_u32 s14, s14, 2097152
s_lshr_b32 s11, s4, 4
s_lshl2_add_u32 s11, s11, s7
s_lshl_b32 s11, s11, 11
s_and_b32 s12, s4, 15
s_lshl4_add_u32 s11, s12, s11
v_lshlrev_b32 v31, 4, v1
s_xor_b32 s12, s3, s6
s_and_b32 s12, s12, 4
s_lshl_b32 s12, s12, 11
v_or_b32 v101, s12, v31
s_lshl_b32 s15, s5, 14
s_add_u32 s15, s15, s14
s_lshl_b32 s10, s10, 12
s_add_u32 s15, s15, s10
s_and_b32 s10, s7, 1
s_lshl_b32 s12, s10, 13
s_add_u32 s15, s15, s12
s_add_u32 s14, s14, s11
v_lshlrev_b32 v88, 13, v3
v_lshl_add_u32 v88, v2, 8, v88
v_lshlrev_b32 v89, 8, v3
v_lshlrev_b32 v90, 3, v3
s_lshr_b32 s11, s4, 4
s_lshl3_add_u32 s10, s3, s11
s_lshl2_add_u32 s96, s10, s7
s_lshl_b32 s96, s96, 10
s_and_b32 s12, s4, 15
s_lshl4_add_u32 s96, s12, s96
s_add_u32 s96, s96, 544768
s_lshl_b32 s97, s10, 7
s_lshl3_add_u32 s97, s12, s97
s_add_u32 s97, s97, 528384
s_lshl2_add_u32 s10, s3, s5
s_and_b32 s11, s7, 1
s_lshl1_add_u32 s10, s10, s11
s_lshr_b32 s11, s7, 1
s_lshl1_add_u32 s98, s10, s11
s_lshl_b32 s98, s98, 11
s_add_u32 s98, s98, 544768
s_lshl_b32 s99, s10, 7
s_add_u32 s99, s99, 528384
v_lshlrev_b32 v100, 9, v2
v_lshl_add_u32 v100, v3, 4, v100
v_add_u32 v100, 133632, v100
s_lshr_b32 s10, s3, 1
s_lshl2_add_u32 s56, s6, s10
s_and_b32 s10, s3, 1
s_lshl2_add_u32 s56, s56, s10
s_lshl2_add_u32 s56, s56, s5
s_lshl_b32 s56, s56, 10
s_add_u32 s56, s56, 1376256
s_add_u32 s63, s56, 8192
v_lshrrev_b32 v119, 1, v1
v_lshlrev_b32 v119, 10, v119
v_and_b32 v16, 1, v1
v_lshl_add_u32 v119, v16, 4, v119
s_lshl_b32 s60, s3, 15
s_lshl_b32 s11, s4, 5
s_add_u32 s60, s60, s11
s_add_u32 s62, s60, 1069056
s_add_u32 s60, s60, 1376256
v_lshl_add_u32 v117, v2, 13, v119
s_lshl_b32 s60, s3, 16
s_add_u32 s60, s60, s11
s_add_u32 s60, s60, 1376256
s_mov_b32 s13, 0x3e0293ee
s_mov_b32 s12, s13
v_mov_b32 v124, 0x3f803f80
v_mov_b32 v125, 0x3f803f80
v_mov_b32 v126, 0x3f803f80
v_mov_b32 v127, 0x3f803f80
s_lshl_b32 s57, s7, 3
s_lshr_b32 s57, 201852420, s57
s_and_b32 s57, s57, 0xff
s_waitcnt vmcnt(0)
s_mov_b64 exec, 1
ds_add_u32 v8, v6 offset:36
s_mov_b64 exec, -1
s_branch W_5
W_4:
s_sleep 1
W_5:
ds_read_b32 v9, v8 offset:4
s_sub_u32 s46, s46, 1
s_cbranch_scc1 L_end
s_waitcnt lgkmcnt(0)
v_cmp_gt_u32 vcc, s57, v9
s_cbranch_vccnz W_4
ds_read_b128 v[32:35], v10 offset:0
ds_read_b128 v[36:39], v11 offset:0
ds_read_b128 v[40:43], v12 offset:0
ds_read_b128 v[44:47], v13 offset:0
ds_read_b128 v[48:51], v10 offset:4096
ds_read_b128 v[52:55], v11 offset:4096
ds_read_b128 v[56:59], v12 offset:4096
ds_read_b128 v[60:63], v13 offset:4096
W_6:
ds_read_b32 v9, v8 offset:12
ds_read_b128 v[64:67], v102
ds_read_b128 v[68:71], v103
ds_read_b128 v[72:75], v104
ds_read_b128 v[76:79], v105
s_sub_u32 s46, s46, 1
s_cbranch_scc1 L_end
s_waitcnt lgkmcnt(4)
v_cmp_gt_u32 vcc, 1, v9
s_cbranch_vccnz W_6
v_readfirstlane_b32 s47, v9
s_nop 0
s_cmp_lg_u32 s47, 1
s_cbranch_scc1 L_qrem
L_qgo:
s_waitcnt lgkmcnt(3)
v_mfma_f32_16x16x32_bf16 v[16:19], v[32:35], v[64:67], 0
s_waitcnt lgkmcnt(2)
v_mfma_f32_16x16x32_bf16 v[16:19], v[36:39], v[68:71], v[16:19]
s_waitcnt lgkmcnt(1)
v_mfma_f32_16x16x32_bf16 v[16:19], v[40:43], v[72:75], v[16:19]
s_waitcnt lgkmcnt(0)
v_mfma_f32_16x16x32_bf16 v[16:19], v[44:47], v[76:79], v[16:19]
v_mfma_f32_16x16x32_bf16 v[20:23], v[48:51], v[64:67], 0
v_mfma_f32_16x16x32_bf16 v[20:23], v[52:55], v[68:71], v[20:23]
v_mfma_f32_16x16x32_bf16 v[20:23], v[56:59], v[72:75], v[20:23]
v_mfma_f32_16x16x32_bf16 v[20:23], v[60:63], v[76:79], v[20:23]
v_mov_b32 v40, s44
v_mov_b32 v47, s44
v_mov_b32 v123, s44
s_nop 0
v_add_f32_dpp v16, v16, v16 row_ror:4 row_mask:0xf bank_mask:0xf
v_add_f32_dpp v17, v17, v17 row_ror:4 row_mask:0xf bank_mask:0xf
v_add_f32_dpp v18, v18, v18 row_ror:4 row_mask:0xf bank_mask:0xf
v_add_f32_dpp v19, v19, v19 row_ror:4 row_mask:0xf bank_mask:0xf
v_add_f32_dpp v16, v16, v16 row_ror:8 row_mask:0xf bank_mask:0xf
v_add_f32_dpp v17, v17, v17 row_ror:8 row_mask:0xf bank_mask:0xf
v_add_f32_dpp v18, v18, v18 row_ror:8 row_mask:0xf bank_mask:0xf
v_add_f32_dpp v19, v19, v19 row_ror:8 row_mask:0xf bank_mask:0xf
v_max3_f32 v10, v16, v17, v18
v_add_f32_dpp v20, v20, v20 row_ror:4 row_mask:0xf bank_mask:0xf
v_add_f32_dpp v21, v21, v21 row_ror:4 row_mask:0xf bank_mask:0xf
v_add_f32_dpp v22, v22, v22 row_ror:4 row_mask:0xf bank_mask:0xf
v_add_f32_dpp v23, v23, v23 row_ror:4 row_mask:0xf bank_mask:0xf
v_add_f32_dpp v20, v20, v20 row_ror:8 row_mask:0xf bank_mask:0xf
v_add_f32_dpp v21, v21, v21 row_ror:8 row_mask:0xf bank_mask:0xf
v_add_f32_dpp v22, v22, v22 row_ror:8 row_mask:0xf bank_mask:0xf
v_add_f32_dpp v23, v23, v23 row_ror:8 row_mask:0xf bank_mask:0xf
v_max3_f32 v10, v10, v19, v20
v_max3_f32 v11, v21, v22, v23
v_max_f32 v10, v10, v11
v_max_f32 v11, v10, v11
s_nop 1
v_permlane16_swap_b32 v11, v10
v_max_f32 v10, v11, v10
v_max_f32 v11, v11, v10
s_nop 1
v_permlane32_swap_b32 v11, v10
v_max_f32 v10, v11, v10
v_or_b32 v10, 1, v10
ds_write_b32 v24, v10
ds_read_b128 v[32:35], v15
ds_read_b32 v9, v8 offset:4
ds_read_b64_tr_b16 v[160:161], v28 offset:0
ds_read_b64_tr_b16 v[162:163], v28 offset:4096
ds_read_b64_tr_b16 v[164:165], v29 offset:0
ds_read_b64_tr_b16 v[166:167], v29 offset:4096
ds_read_b64_tr_b16 v[168:169], v28 offset:8192
ds_read_b64_tr_b16 v[170:171], v28 offset:12288
ds_read_b64_tr_b16 v[172:173], v29 offset:8192
ds_read_b64_tr_b16 v[174:175], v29 offset:12288
ds_read_b64_tr_b16 v[176:177], v28 offset:16384
ds_read_b64_tr_b16 v[178:179], v28 offset:20480
ds_read_b64_tr_b16 v[180:181], v29 offset:16384
ds_read_b64_tr_b16 v[182:183], v29 offset:20480
s_waitcnt lgkmcnt(13)
s_branch L_mx2
L_mx:
ds_read_b128 v[32:35], v15
s_sub_u32 s46, s46, 1
s_cbranch_scc1 L_end
s_waitcnt lgkmcnt(0)
L_mx2:
v_min3_u32 v11, v32, v33, v34
v_max3_f32 v10, v32, v33, v34
v_min_u32 v11, v11, v35
v_max_f32 v10, v10, v35
v_cmp_eq_u32 vcc, 0, v11
v_mul_f32 v116, s13, v10
s_cbranch_vccnz L_mx
v_pk_fma_f32 v[16:17], v[16:17], s[12:13], v[116:117] op_sel_hi:[1,1,0] neg_lo:[0,0,1] neg_hi:[0,0,1]
v_pk_fma_f32 v[18:19], v[18:19], s[12:13], v[116:117] op_sel_hi:[1,1,0] neg_lo:[0,0,1] neg_hi:[0,0,1]
v_pk_fma_f32 v[20:21], v[20:21], s[12:13], v[116:117] op_sel_hi:[1,1,0] neg_lo:[0,0,1] neg_hi:[0,0,1]
v_pk_fma_f32 v[22:23], v[22:23], s[12:13], v[116:117] op_sel_hi:[1,1,0] neg_lo:[0,0,1] neg_hi:[0,0,1]
v_exp_f32 v16, v16
v_exp_f32 v17, v17
v_exp_f32 v18, v18
v_exp_f32 v19, v19
v_exp_f32 v20, v20
v_exp_f32 v21, v21
v_exp_f32 v22, v22
v_exp_f32 v23, v23
v_cvt_pk_bf16_f32 v32, v16, v17
v_cvt_pk_bf16_f32 v33, v18, v19
v_cvt_pk_bf16_f32 v34, v20, v21
v_cvt_pk_bf16_f32 v35, v22, v23
ds_write_b128 v26, v[32:35]
ds_write_b32 v14, v6
L_pw:
ds_read_b128 v[36:39], v8 offset:192
ds_read_b128 v[64:67], v25 offset:0
ds_read_b128 v[68:71], v25 offset:1024
ds_read_b128 v[72:75], v25 offset:2048
ds_read_b128 v[76:79], v25 offset:3072
ds_read_b32 v118, v8 offset:4
ds_read_b64_tr_b16 v[184:185], v28 offset:24576
ds_read_b64_tr_b16 v[186:187], v28 offset:28672
ds_read_b64_tr_b16 v[188:189], v29 offset:24576
ds_read_b64_tr_b16 v[190:191], v29 offset:28672
v_mov_b32 v41, v116
s_sub_u32 s46, s46, 1
s_cbranch_scc1 L_end
s_waitcnt lgkmcnt(9)
v_min3_u32 v11, v36, v37, v38
v_min_u32 v11, v11, v39
v_cmp_eq_u32 vcc, 0, v11
s_cbranch_vccnz L_pw
v_cmp_gt_u32 vcc, 18, v9
s_cbranch_vccz L_v012
s_branch W_8
W_7:
s_sleep 2
W_8:
ds_read_b32 v9, v8 offset:4
ds_read_b64_tr_b16 v[160:161], v28 offset:0
ds_read_b64_tr_b16 v[162:163], v28 offset:4096
ds_read_b64_tr_b16 v[164:165], v29 offset:0
ds_read_b64_tr_b16 v[166:167], v29 offset:4096
ds_read_b64_tr_b16 v[168:169], v28 offset:8192
ds_read_b64_tr_b16 v[170:171], v28 offset:12288
ds_read_b64_tr_b16 v[172:173], v29 offset:8192
ds_read_b64_tr_b16 v[174:175], v29 offset:12288
ds_read_b64_tr_b16 v[176:177], v28 offset:16384
ds_read_b64_tr_b16 v[178:179], v28 offset:20480
ds_read_b64_tr_b16 v[180:181], v29 offset:16384
ds_read_b64_tr_b16 v[182:183], v29 offset:20480
s_sub_u32 s46, s46, 1
s_cbranch_scc1 L_end
s_waitcnt lgkmcnt(12)
v_cmp_gt_u32 vcc, 18, v9
s_cbranch_vccnz W_7
s_waitcnt lgkmcnt(0)
L_v012:
s_waitcnt lgkmcnt(8)
v_mfma_f32_16x16x32_bf16 v[16:19], v[160:163], v[64:67], 0
v_mfma_f32_16x16x32_bf16 v[20:23], v[164:167], v[64:67], 0
v_mfma_f32_16x16x32_bf16 v[56:59], v[124:127], v[64:67], 0
s_waitcnt lgkmcnt(7)
v_mfma_f32_16x16x32_bf16 v[16:19], v[168:171], v[68:71], v[16:19]
v_mfma_f32_16x16x32_bf16 v[20:23], v[172:175], v[68:71], v[20:23]
v_mfma_f32_16x16x32_bf16 v[56:59], v[124:127], v[68:71], v[56:59]
s_waitcnt lgkmcnt(6)
v_mfma_f32_16x16x32_bf16 v[16:19], v[176:179], v[72:75], v[16:19]
v_mfma_f32_16x16x32_bf16 v[20:23], v[180:183], v[72:75], v[20:23]
v_mfma_f32_16x16x32_bf16 v[56:59], v[124:127], v[72:75], v[56:59]
s_waitcnt lgkmcnt(4)
v_mfma_f32_16x16x32_bf16 v[56:59], v[124:127], v[76:79], v[56:59]
v_cmp_gt_u32 vcc, 20, v118
s_cbranch_vccz L_v3
W_9:
ds_read_b32 v9, v8 offset:4
ds_read_b64_tr_b16 v[184:185], v28 offset:24576
ds_read_b64_tr_b16 v[186:187], v28 offset:28672
ds_read_b64_tr_b16 v[188:189], v29 offset:24576
ds_read_b64_tr_b16 v[190:191], v29 offset:28672
s_sub_u32 s46, s46, 1
s_cbranch_scc1 L_end
s_waitcnt lgkmcnt(4)
v_cmp_gt_u32 vcc, 20, v9
s_cbranch_vccnz W_9
L_v3:
s_waitcnt lgkmcnt(2)
v_mfma_f32_16x16x32_bf16 v[16:19], v[184:187], v[76:79], v[16:19]
s_waitcnt lgkmcnt(0)
v_mfma_f32_16x16x32_bf16 v[20:23], v[188:191], v[76:79], v[20:23]
s_nop 1
v_min_u32 v46, -2, v56
v_mov_b32 v93, v41
s_mov_b32 exec_lo, 0x000f000f
s_mov_b32 exec_hi, 0x000f000f
s_cmp_eq_u32 s47, 1
v_mov_b32 v92, v46
v_cvt_pk_bf16_f32 v42, v16, v17
v_cvt_pk_bf16_f32 v43, v18, v19
v_min_u32 v42, -2, v42
v_cvt_pk_bf16_f32 v44, v20, v21
v_cvt_pk_bf16_f32 v45, v22, v23
s_cbranch_scc0 L_orem
buffer_store_dwordx4 v[42:45], v88, s[40:43], s96 offen
s_lshl_b64 exec, 1, s7
buffer_store_dwordx2 v[92:93], v89, s[40:43], s97 offen
L_ost:
s_mov_b64 exec, -1
W_10:
ds_read_b32 v9, v8 offset:4
s_sub_u32 s46, s46, 1
s_cbranch_scc1 L_end
s_waitcnt lgkmcnt(0)
v_cmp_gt_u32 vcc, 23, v9
s_cbranch_vccnz W_10
buffer_load_dwordx2 v[48:49], v90, s[40:43], s99 offen sc1
buffer_load_dwordx4 v[50:53], v31, s[40:43], s98 offen sc1
buffer_load_dwordx4 v[58:61], v31, s[40:43], s98 offen offset:1024 sc1
ds_read_b64_tr_b16 v[128:129], v96 offset:0
ds_read_b64_tr_b16 v[130:131], v96 offset:2048
ds_read_b64_tr_b16 v[132:133], v97 offset:0
ds_read_b64_tr_b16 v[134:135], v97 offset:2048
ds_read_b64_tr_b16 v[136:137], v98 offset:0
ds_read_b64_tr_b16 v[138:139], v98 offset:2048
ds_read_b64_tr_b16 v[140:141], v99 offset:0
ds_read_b64_tr_b16 v[142:143], v99 offset:2048
s_barrier
ds_read_b64_tr_b16 v[144:145], v96 offset:4096
ds_read_b64_tr_b16 v[146:147], v96 offset:6144
ds_read_b64_tr_b16 v[148:149], v97 offset:4096
ds_read_b64_tr_b16 v[150:151], v97 offset:6144
ds_read_b64_tr_b16 v[152:153], v98 offset:4096
ds_read_b64_tr_b16 v[154:155], v98 offset:6144
ds_read_b64_tr_b16 v[156:157], v99 offset:4096
ds_read_b64_tr_b16 v[158:159], v99 offset:6144
ds_read_b32 v9, v8 offset:48
s_cmp_eq_u32 s47, 1
s_cbranch_scc1 L_opoll
s_branch L_rpoll
L_oretry:
s_mov_b64 exec, vcc
buffer_load_dwordx2 v[48:49], v90, s[40:43], s99 offen sc1
buffer_load_dwordx4 v[50:53], v31, s[40:43], s98 offen sc1
buffer_load_dwordx4 v[58:61], v31, s[40:43], s98 offen offset:1024 sc1
s_mov_b64 exec, -1
s_sub_u32 s46, s46, 1
s_cbranch_scc1 L_end
L_opoll:
s_waitcnt vmcnt(0) lgkmcnt(0)
v_max3_u32 v10, v48, v50, v58
v_cmp_eq_u32 vcc, -1, v10
s_cbranch_vccnz L_oretry
L_ogot:
v_mfma_f32_16x16x32_bf16 v[32:35], v[50:53], v[128:131], 0
v_max_f32_dpp v20, v49, v49 quad_perm:[1,0,3,2] row_mask:0xf bank_mask:0xf
v_mfma_f32_16x16x32_bf16 v[36:39], v[50:53], v[132:135], 0
s_nop 0
v_max_f32_dpp v20, v20, v20 quad_perm:[2,3,0,1] row_mask:0xf bank_mask:0xf
v_mfma_f32_16x16x32_bf16 v[40:43], v[50:53], v[136:139], 0
s_nop 0
v_max_f32_dpp v20, v20, v20 row_half_mirror row_mask:0xf bank_mask:0xf
v_sub_f32 v21, v49, v20
v_exp_f32 v21, v21
v_mfma_f32_16x16x32_bf16 v[44:47], v[50:53], v[140:143], 0
v_mul_f32 v22, v48, v21
v_mov_b32 v23, v21
v_mfma_f32_16x16x32_bf16 v[32:35], v[58:61], v[144:147], v[32:35]
v_add_f32_dpp v22, v22, v22 quad_perm:[1,0,3,2] row_mask:0xf bank_mask:0xf
v_mov_b32_dpp v23, v21 row_ror:12 row_mask:0x2 bank_mask:0xf
v_mfma_f32_16x16x32_bf16 v[36:39], v[58:61], v[148:151], v[36:39]
v_add_f32_dpp v22, v22, v22 quad_perm:[2,3,0,1] row_mask:0xf bank_mask:0xf
v_mov_b32_dpp v23, v21 row_ror:8 row_mask:0x4 bank_mask:0xf
v_mfma_f32_16x16x32_bf16 v[40:43], v[58:61], v[152:155], v[40:43]
v_add_f32_dpp v22, v22, v22 row_half_mirror row_mask:0xf bank_mask:0xf
v_mov_b32_dpp v23, v21 row_ror:4 row_mask:0x8 bank_mask:0xf
v_rcp_f32 v22, v22
v_mfma_f32_16x16x32_bf16 v[44:47], v[58:61], v[156:159], v[44:47]
v_mul_f32 v21, v22, v23
s_nop 1
v_mul_f32_dpp v21, v22, v23 row_ror:8 row_mask:0xc bank_mask:0xf
s_nop 1
v_mul_f32_dpp v16, v21, v32 row_newbcast:0 row_mask:0xf bank_mask:0xf
v_mul_f32_dpp v17, v21, v36 row_newbcast:0 row_mask:0xf bank_mask:0xf
v_mul_f32_dpp v18, v21, v40 row_newbcast:0 row_mask:0xf bank_mask:0xf
v_mul_f32_dpp v19, v21, v44 row_newbcast:0 row_mask:0xf bank_mask:0xf
v_fmac_f32_dpp v16, v21, v33 row_newbcast:1 row_mask:0xf bank_mask:0xf
v_fmac_f32_dpp v17, v21, v37 row_newbcast:1 row_mask:0xf bank_mask:0xf
v_fmac_f32_dpp v18, v21, v41 row_newbcast:1 row_mask:0xf bank_mask:0xf
v_fmac_f32_dpp v19, v21, v45 row_newbcast:1 row_mask:0xf bank_mask:0xf
v_fmac_f32_dpp v16, v21, v34 row_newbcast:2 row_mask:0xf bank_mask:0xf
v_fmac_f32_dpp v17, v21, v38 row_newbcast:2 row_mask:0xf bank_mask:0xf
v_fmac_f32_dpp v18, v21, v42 row_newbcast:2 row_mask:0xf bank_mask:0xf
v_fmac_f32_dpp v19, v21, v46 row_newbcast:2 row_mask:0xf bank_mask:0xf
v_fmac_f32_dpp v16, v21, v35 row_newbcast:3 row_mask:0xf bank_mask:0xf
v_fmac_f32_dpp v17, v21, v39 row_newbcast:3 row_mask:0xf bank_mask:0xf
v_fmac_f32_dpp v18, v21, v43 row_newbcast:3 row_mask:0xf bank_mask:0xf
v_fmac_f32_dpp v19, v21, v47 row_newbcast:3 row_mask:0xf bank_mask:0xf
ds_write_b128 v26, v[16:19] offset:4096
v_add_u32 v117, v117, v9
s_cmp_lg_u32 s7, 0
s_waitcnt lgkmcnt(0)
s_barrier
s_cbranch_scc1 L_wb
ds_read_b128 v[48:51], v100 offset:0
ds_read_b128 v[52:55], v100 offset:256
ds_read_b128 v[56:59], v100 offset:2048
ds_read_b128 v[60:63], v100 offset:2304
s_waitcnt lgkmcnt(2)
v_pk_add_f32 v[48:49], v[48:49], v[52:53]
v_pk_add_f32 v[50:51], v[50:51], v[54:55]
s_waitcnt lgkmcnt(1)
v_pk_add_f32 v[48:49], v[48:49], v[56:57]
v_pk_add_f32 v[50:51], v[50:51], v[58:59]
s_waitcnt lgkmcnt(0)
v_pk_add_f32 v[48:49], v[48:49], v[60:61]
v_pk_add_f32 v[50:51], v[50:51], v[62:63]
v_perm_b32 v120, v48, v51, s50
v_perm_b32 v121, v49, v51, s51
v_perm_b32 v122, v50, v51, s52
buffer_store_dwordx4 v[120:123], v31, s[40:43], s56 offen sc1
buffer_store_dwordx4 v[120:123], v31, s[40:43], s63 offen sc1
s_branch L_end
L_wb:
s_cmp_lg_u32 s7, 1
s_cbranch_scc1 L_end
L_mpoll:
buffer_load_dwordx4 v[32:35], v119, s[40:43], s62 offen sc1
v_lshlrev_b32 v14, 3, v1
v_add_u32 v14, 138368, v14
ds_read_b64 v[12:13], v14
s_mov_b32 s53, 0x04000c0c
s_mov_b32 s54, 0x0706000c
s_mov_b32 s50, 4096
s_mov_b32 s51, 0x20000
s_mov_b32 s48, s36
s_mov_b32 s49, s37
s_mov_b32 s56, 0x00030003
s_mov_b32 s57, s56
v_and_b32 v11, 1, v1
v_lshlrev_b32 v14, 5, v2
v_lshl_add_u32 v14, v11, 1, v14
s_lshl_b32 s11, s5, 10
s_lshl_b32 s12, s3, 7
s_add_u32 s11, s11, s12
s_lshl2_add_u32 s11, s6, s11
s_sleep 8
buffer_load_dwordx4 v[16:19], v117, s[40:43], s60 offen sc1
s_sleep 2
buffer_load_dwordx4 v[20:23], v117, s[40:43], s60 offen sc1
s_sub_u32 s46, s46, 1
s_cbranch_scc1 L_end
s_waitcnt vmcnt(2)
v_cmp_ne_u32 vcc, s44, v35
s_cbranch_vccnz L_mpoll
v_perm_b32 v35, v32, v33, s53
v_perm_b32 v35, v35, v34, s54
v_permlane32_swap_b32 v32, v34
s_nop 0
v_permlane32_swap_b32 v33, v35
v_add_f32 v32, v32, v34
v_add_f32 v33, v33, v35
s_nop 1
v_permlane16_swap_b32 v32, v33
v_add_f32 v32, v32, v33
s_nop 1
v_add_f32_dpp v32, v32, v32 row_ror:8 row_mask:0xf bank_mask:0xf
s_nop 1
v_add_f32_dpp v32, v32, v32 row_ror:4 row_mask:0xf bank_mask:0xf
s_nop 1
v_add_f32_dpp v32, v32, v32 row_ror:2 row_mask:0xf bank_mask:0xf
s_waitcnt lgkmcnt(0)
v_cvt_pk_bf16_f32 v32, v32, v32
v_lshlrev_b32 v32, 16, v32
v_add_f32 v32, v32, v12
v_cvt_pk_bf16_f32 v32, v32, v32
v_lshlrev_b32 v32, 16, v32
v_mul_f32 v33, 0xbfb8aa3b, v32
v_exp_f32 v33, v33
s_nop 0
v_add_f32 v33, 1.0, v33
v_rcp_f32 v33, v33
s_nop 0
v_mul_f32 v12, v32, v33
v_cvt_pk_bf16_f32 v12, v12, v12
v_lshlrev_b32 v12, 16, v12
L_fpoll:
s_waitcnt vmcnt(1)
v_cmp_ne_u32 vcc, s44, v19
s_cbranch_vccz L_fdone
buffer_load_dwordx4 v[16:19], v117, s[40:43], s60 offen sc1
s_sub_u32 s46, s46, 1
s_cbranch_scc1 L_end
s_waitcnt vmcnt(1)
v_cmp_ne_u32 vcc, s44, v23
s_cbranch_vccz L_fdoneB
buffer_load_dwordx4 v[20:23], v117, s[40:43], s60 offen sc1
s_branch L_fpoll
L_fdoneB:
v_perm_b32 v23, v20, v21, s53
v_perm_b32 v23, v23, v22, s54
v_permlane32_swap_b32 v20, v22
s_nop 0
v_permlane32_swap_b32 v21, v23
v_add_f32 v20, v20, v22
v_add_f32 v21, v21, v23
s_nop 1
v_permlane16_swap_b32 v20, v21
v_add_f32 v20, v20, v21
s_nop 1
v_add_f32_dpp v20, v20, v20 row_ror:8 row_mask:0xf bank_mask:0xf
s_nop 1
v_add_f32_dpp v20, v20, v20 row_ror:4 row_mask:0xf bank_mask:0xf
s_nop 1
v_add_f32_dpp v20, v20, v20 row_ror:2 row_mask:0xf bank_mask:0xf
v_cvt_pk_bf16_f32 v20, v20, v20
v_lshlrev_b32 v20, 16, v20
v_mul_f32 v20, v20, v12
v_cvt_pk_bf16_f32 v20, v20, v20
v_lshlrev_b32 v20, 16, v20
v_add_f32 v20, v20, v13
s_mov_b64 exec, s[56:57]
v_cvt_pk_bf16_f32 v20, v20, v20
buffer_store_short v20, v14, s[48:51], s11 offen
s_branch L_epoch
L_fdone:
v_perm_b32 v19, v16, v17, s53
v_perm_b32 v19, v19, v18, s54
v_permlane32_swap_b32 v16, v18
s_nop 0
v_permlane32_swap_b32 v17, v19
v_add_f32 v16, v16, v18
v_add_f32 v17, v17, v19
s_nop 1
v_permlane16_swap_b32 v16, v17
v_add_f32 v16, v16, v17
s_nop 1
v_add_f32_dpp v16, v16, v16 row_ror:8 row_mask:0xf bank_mask:0xf
s_nop 1
v_add_f32_dpp v16, v16, v16 row_ror:4 row_mask:0xf bank_mask:0xf
s_nop 1
v_add_f32_dpp v16, v16, v16 row_ror:2 row_mask:0xf bank_mask:0xf
v_cvt_pk_bf16_f32 v16, v16, v16
v_lshlrev_b32 v16, 16, v16
v_mul_f32 v16, v16, v12
v_cvt_pk_bf16_f32 v16, v16, v16
v_lshlrev_b32 v16, 16, v16
v_add_f32 v16, v16, v13
s_mov_b64 exec, s[56:57]
v_cvt_pk_bf16_f32 v16, v16, v16
buffer_store_short v16, v14, s[48:51], s11 offen
L_epoch:
s_cmp_lg_u32 s2, 0
s_cbranch_scc1 L_end
s_mov_b64 exec, 1
buffer_store_dword v123, v8, s[40:43], 0 offen
s_branch L_end
L_qrem:
s_mov_b32 exec_lo, 0x000f000f
s_mov_b32 exec_hi, 0x000f000f
buffer_store_dwordx4 v[108:111], v106, s[40:43], s58 offen sc1
buffer_store_dwordx4 v[112:115], v107, s[40:43], s59 offen sc1
s_mov_b64 exec, -1
L_qrem2:
ds_read_b32 v9, v8 offset:12
ds_read_b128 v[64:67], v102
ds_read_b128 v[68:71], v103
ds_read_b128 v[72:75], v104
ds_read_b128 v[76:79], v105
s_sub_u32 s46, s46, 1
s_cbranch_scc1 L_end
s_waitcnt lgkmcnt(0)
v_readfirstlane_b32 s47, v9
s_nop 0
s_cmp_eq_u32 s47, 4
s_cbranch_scc0 L_qgo
s_sleep 2
s_branch L_qrem2
L_rpoll:
buffer_load_dwordx4 v[48:51], v31, s[40:43], s15 offen offset:0 sc1
buffer_load_dwordx4 v[52:55], v31, s[40:43], s15 offen offset:1024 sc1
buffer_load_dwordx4 v[56:59], v31, s[40:43], s15 offen offset:2048 sc1
buffer_load_dwordx4 v[60:63], v31, s[40:43], s15 offen offset:3072 sc1
s_sub_u32 s46, s46, 1
s_cbranch_scc1 L_end
s_waitcnt vmcnt(0) lgkmcnt(0)
v_xor_b32 v10, s44, v48
v_bitop3_b32 v10, v55, s44, v10 bitop3:0xbe
v_bitop3_b32 v10, v56, s44, v10 bitop3:0xbe
v_bitop3_b32 v10, v63, s44, v10 bitop3:0xbe
v_cmp_ne_u32 vcc, 0, v10
s_cbranch_vccnz L_rpoll
v_mov_b32 v48, v54
s_branch L_ogot
L_orem:
buffer_store_dwordx4 v[40:43], v30, s[40:43], s14 offen sc1
buffer_store_dwordx4 v[44:47], v30, s[40:43], s14 offen offset:1024 sc1
s_branch L_ost
L_P:
s_setprio 3
s_getreg_b32 s45, hwreg(HW_REG_XCC_ID, 0, 4)
v_and_b32 v5, 3, v1
s_lshl_b32 s10, s3, 15
s_lshl_b32 s12, s4, 10
s_add_u32 s12, s12, s10
s_waitcnt lgkmcnt(0)
s_lshl_b32 s11, s5, 13
s_add_u32 s10, s10, s11
s_add_u32 s10, s10, 4096
s_add_u32 s15, s10, 4096
v_lshlrev_b32 v10, 4, v1
v_lshrrev_b32 v11, 5, v1
v_and_b32 v12, 31, v1
v_lshlrev_b32 v13, 3, v12
v_lshlrev_b32 v14, 4, v11
v_xor_b32 v13, v13, v14
v_lshl_add_u32 v13, v11, 8, v13
v_add_u32 v22, 125440, v13
v_xor_b32 v23, 32, v22
v_xor_b32 v24, 64, v22
v_xor_b32 v25, 96, v22
v_xor_b32 v26, 128, v22
v_xor_b32 v27, 160, v22
v_xor_b32 v28, 192, v22
v_xor_b32 v29, 224, v22
s_mov_b32 s14, 6
s_waitcnt lgkmcnt(0)
s_sleep 40
s_branch W_12
W_11:
s_sleep 1
W_12:
ds_read_b32 v9, v8 offset:28
ds_read_b32 v15, v8 offset:52
s_sub_u32 s46, s46, 1
s_cbranch_scc1 L_end
s_waitcnt lgkmcnt(1)
v_cmp_gt_u32 vcc, 4, v9
s_cbranch_vccnz W_11
s_waitcnt lgkmcnt(0)
v_readfirstlane_b32 s44, v15
s_sleep 4
L_qpoll:
buffer_load_dwordx4 v[32:35], v10, s[40:43], s10 offen offset:0 sc1
buffer_load_dwordx4 v[36:39], v10, s[40:43], s10 offen offset:1024 sc1
buffer_load_dwordx4 v[40:43], v10, s[40:43], s10 offen offset:2048 sc1
buffer_load_dwordx4 v[44:47], v10, s[40:43], s10 offen offset:3072 sc1
buffer_load_dwordx4 v[48:51], v10, s[40:43], s15 offen offset:0 sc1
buffer_load_dwordx4 v[52:55], v10, s[40:43], s15 offen offset:1024 sc1
buffer_load_dwordx4 v[56:59], v10, s[40:43], s15 offen offset:2048 sc1
buffer_load_dwordx4 v[60:63], v10, s[40:43], s15 offen offset:3072 sc1
s_sub_u32 s46, s46, 1
s_cbranch_scc1 L_end
s_waitcnt vmcnt(0)
v_xor_b32 v15, s44, v35
v_bitop3_b32 v15, v39, s44, v15 bitop3:0xbe
v_bitop3_b32 v15, v43, s44, v15 bitop3:0xbe
v_bitop3_b32 v15, v47, s44, v15 bitop3:0xbe
v_bitop3_b32 v15, v51, s44, v15 bitop3:0xbe
v_bitop3_b32 v15, v55, s44, v15 bitop3:0xbe
v_bitop3_b32 v15, v59, s44, v15 bitop3:0xbe
v_bitop3_b32 v15, v63, s44, v15 bitop3:0xbe
v_cmp_ne_u32 vcc, 0, v15
s_cbranch_vccz L_qgot
s_mov_b64 exec, vcc
s_sub_u32 s14, s14, 1
s_cbranch_scc0 L_qpoll
v_mov_b32 v15, 4
ds_write_b32 v8, v15 offset:12
s_branch L_qpoll
L_qgot:
s_mov_b64 exec, -1
v_xor_b32 v15, s45, v34
ds_write_b64 v22, v[32:33] offset:0
v_bitop3_b32 v15, v38, s45, v15 bitop3:0xbe
ds_write_b64 v23, v[36:37] offset:512
v_bitop3_b32 v15, v42, s45, v15 bitop3:0xbe
ds_write_b64 v24, v[40:41] offset:1024
v_bitop3_b32 v15, v46, s45, v15 bitop3:0xbe
ds_write_b64 v25, v[44:45] offset:1536
v_bitop3_b32 v15, v50, s45, v15 bitop3:0xbe
ds_write_b64 v26, v[48:49] offset:2048
v_bitop3_b32 v15, v54, s45, v15 bitop3:0xbe
ds_write_b64 v27, v[52:53] offset:2560
v_bitop3_b32 v15, v58, s45, v15 bitop3:0xbe
ds_write_b64 v28, v[56:57] offset:3072
v_bitop3_b32 v15, v62, s45, v15 bitop3:0xbe
ds_write_b64 v29, v[60:61] offset:3584
v_and_b32 v15, 15, v15
v_cmp_ne_u32 vcc, 0, v15
s_nop 0
s_cmp_eq_u64 vcc, 0
s_cselect_b32 s47, 1, 2
v_mov_b32 v15, s47
ds_write_b32 v8, v15 offset:12
v_add3_u32 v16, v34, v38, v42
v_add3_u32 v17, v46, v50, v54
v_add3_u32 v16, v16, v58, v62
v_add_u32 v16, v16, v17
s_nop 1
v_add_u32_dpp v16, v16, v16 quad_perm:[1,0,3,2] row_mask:0xf bank_mask:0xf
s_nop 1
v_add_u32_dpp v16, v16, v16 quad_perm:[2,3,0,1] row_mask:0xf bank_mask:0xf
s_nop 1
v_add_u32_dpp v16, v16, v16 row_half_mirror row_mask:0xf bank_mask:0xf
s_nop 1
v_add_u32_dpp v16, v16, v16 row_mirror row_mask:0xf bank_mask:0xf
s_nop 1
v_add_u32_dpp v16, v16, v16 row_bcast:15 row_mask:0xa bank_mask:0xf
s_nop 1
v_add_u32_dpp v16, v16, v16 row_bcast:31 row_mask:0xc bank_mask:0xf
s_nop 0
v_readlane_b32 s10, v16, 63
s_nop 0
s_cmp_lt_i32 s10, 0
s_cselect_b32 s10, 0, 8192
v_mov_b32 v15, s10
ds_write_b32 v8, v15 offset:48
s_add_u32 s11, s12, 544768
s_lshl3_add_u32 s9, s3, s6
s_lshl_b32 s9, s9, 7
s_add_u32 s9, s9, 528384
s_lshl2_add_u32 s12, s3, s5
s_lshl4_add_u32 s12, s12, s6
s_lshl_b32 s12, s12, 10
s_add_u32 s12, s12, s10
s_add_u32 s12, s12, 1374208
v_lshlrev_b32 v10, 7, v1
v_add_u32 v11, s12, v10
v_add_u32 v10, s11, v10
v_cmp_gt_u32 vcc, 16, v1
s_nop 1
v_cndmask_b32 v10, v11, v10, vcc
v_writelane_b32 v10, s9, 8
s_mov_b64 exec, 0xff01ff
buffer_load_dword v7, v10, s[40:43], 0 offen
s_branch L_end
L_M:
s_setprio 3
L_M2:
v_bfe_u32 v4, v1, 2, 2
v_and_b32 v5, 3, v1
v_lshl_add_u32 v10, v4, 2, v2
v_lshlrev_b32 v11, 3, v10
v_lshlrev_b32 v10, 4, v1
s_mul_i32 s11, s5, 6
s_add_u32 s11, s11, s3
s_cmp_gt_u32 s3, 0
s_cselect_b32 s15, 2, 0
s_sub_u32 s11, s11, s15
s_lshl_b32 s11, s11, 1
s_lshl2_add_u32 s15, s3, s5
s_add_u32 s15, s15, 48
s_bitcmp1_b32 3, s3
s_cselect_b32 s11, s15, s11
s_lshl3_add_u32 s15, s5, s3
s_lshl_b32 s11, s11, 6
v_and_b32 v24, 1, v1
v_lshlrev_b32 v25, 5, v2
v_lshl_add_u32 v25, v24, 1, v25
s_lshl_b32 s12, s3, 7
s_lshl2_add_u32 s12, s6, s12
s_lshl_b32 s13, s5, 10
s_add_u32 s13, s13, s12
s_mov_b32 s58, 3584
s_mov_b32 s59, 0x20000
s_mov_b32 s62, 1024
s_mov_b32 s63, 0x20000
s_mov_b32 s98, 4096
s_mov_b32 s99, 0x20000
s_waitcnt lgkmcnt(0)
s_mov_b32 s56, s30
s_mov_b32 s57, s31
s_mov_b32 s60, s34
s_mov_b32 s61, s35
s_mov_b32 s96, s16
s_mov_b32 s97, s17
buffer_load_ushort v16, v25, s[60:63], s12 offen
buffer_load_ushort v17, v25, s[96:99], s13 offen
buffer_load_dwordx2 v[14:15], v11, s[56:59], s11 offen
v_mul_u32_u24 v11, 144, v5
v_lshl_add_u32 v11, v2, 4, v11
v_lshrrev_b32 v12, 1, v4
v_lshl_add_u32 v11, v12, 6, v11
v_and_b32 v12, 1, v4
v_lshl_add_u32 v11, v12, 3, v11
v_add_u32 v11, 137728, v11
v_mul_u32_u24 v12, 144, v4
v_lshl_add_u32 v12, v2, 4, v12
v_add_u32 v12, 137728, v12
v_lshl_add_u32 v27, v2, 2, v4
v_bfe_u32 v28, v27, 1, 2
v_lshlrev_b32 v28, 5, v28
v_lshl_add_u32 v28, v27, 7, v28
v_lshl_add_u32 v28, v5, 3, v28
v_add_u32 v28, 59392, v28
v_xor_b32 v29, 32, v28
v_xor_b32 v30, 64, v28
v_xor_b32 v31, 96, v28
v_lshlrev_b32 v13, 3, v1
v_add_u32 v13, 138368, v13
s_waitcnt vmcnt(1) lgkmcnt(0)
v_lshlrev_b32 v16, 16, v16
v_lshlrev_b32 v17, 16, v17
ds_write_b64 v13, v[16:17]
s_branch W_14
W_13:
s_sleep 1
W_14:
ds_read_b32 v9, v8 offset:36
ds_read_b32 v23, v8 offset:52
s_sub_u32 s46, s46, 1
s_cbranch_scc1 L_end
s_waitcnt lgkmcnt(1)
v_cmp_gt_u32 vcc, 4, v9
s_cbranch_vccnz W_13
s_waitcnt lgkmcnt(0)
v_readfirstlane_b32 s44, v23
s_mov_b32 s50, 0x07060503
s_mov_b32 s51, 0x07060502
s_mov_b32 s52, 0x07060501
s_mov_b32 s53, 0x04000c0c
s_mov_b32 s54, 0x0706000c
s_sleep 5
s_lshl2_add_u32 s10, s3, s5
s_lshl_b32 s10, s10, 13
s_add_u32 s10, s10, 266240
s_add_u32 s11, s10, 4096
L_hpoll:
buffer_load_dwordx4 v[32:35], v10, s[40:43], s10 offen offset:0 sc1
buffer_load_dwordx4 v[36:39], v10, s[40:43], s10 offen offset:1024 sc1
buffer_load_dwordx4 v[40:43], v10, s[40:43], s10 offen offset:2048 sc1
buffer_load_dwordx4 v[44:47], v10, s[40:43], s10 offen offset:3072 sc1
buffer_load_dwordx4 v[48:51], v10, s[40:43], s11 offen offset:0 sc1
buffer_load_dwordx4 v[52:55], v10, s[40:43], s11 offen offset:1024 sc1
buffer_load_dwordx4 v[56:59], v10, s[40:43], s11 offen offset:2048 sc1
buffer_load_dwordx4 v[60:63], v10, s[40:43], s11 offen offset:3072 sc1
s_sub_u32 s46, s46, 1
s_cbranch_scc1 L_end
s_waitcnt vmcnt(0)
v_xor_b32 v13, s44, v35
v_bitop3_b32 v13, v39, s44, v13 bitop3:0xbe
v_bitop3_b32 v13, v43, s44, v13 bitop3:0xbe
v_bitop3_b32 v13, v47, s44, v13 bitop3:0xbe
v_bitop3_b32 v13, v51, s44, v13 bitop3:0xbe
v_bitop3_b32 v13, v55, s44, v13 bitop3:0xbe
v_bitop3_b32 v13, v59, s44, v13 bitop3:0xbe
v_bitop3_b32 v13, v63, s44, v13 bitop3:0xbe
v_cmp_ne_u32 vcc, 0, v13
s_cbranch_vccnz L_hpoll
v_perm_b32 v35, v32, v33, s53
v_perm_b32 v35, v35, v34, s54
v_perm_b32 v39, v36, v37, s53
v_perm_b32 v39, v39, v38, s54
v_perm_b32 v43, v40, v41, s53
v_perm_b32 v43, v43, v42, s54
v_perm_b32 v47, v44, v45, s53
v_perm_b32 v47, v47, v46, s54
v_perm_b32 v51, v48, v49, s53
v_perm_b32 v51, v51, v50, s54
v_perm_b32 v55, v52, v53, s53
v_perm_b32 v55, v55, v54, s54
v_perm_b32 v59, v56, v57, s53
v_perm_b32 v59, v59, v58, s54
v_perm_b32 v63, v60, v61, s53
v_perm_b32 v63, v63, v62, s54
v_pk_add_f32 v[32:33], v[32:33], v[48:49]
v_pk_add_f32 v[34:35], v[34:35], v[50:51]
v_pk_add_f32 v[36:37], v[36:37], v[52:53]
v_pk_add_f32 v[38:39], v[38:39], v[54:55]
v_pk_add_f32 v[40:41], v[40:41], v[56:57]
v_pk_add_f32 v[42:43], v[42:43], v[58:59]
v_pk_add_f32 v[44:45], v[44:45], v[60:61]
v_pk_add_f32 v[46:47], v[46:47], v[62:63]
v_pk_add_f32 v[32:33], v[32:33], v[40:41]
v_pk_add_f32 v[34:35], v[34:35], v[42:43]
v_pk_add_f32 v[36:37], v[36:37], v[44:45]
v_pk_add_f32 v[38:39], v[38:39], v[46:47]
v_pk_add_f32 v[32:33], v[32:33], v[36:37]
v_pk_add_f32 v[34:35], v[34:35], v[38:39]
v_cvt_pk_bf16_f32 v36, v32, v33
v_cvt_pk_bf16_f32 v37, v34, v35
v_lshlrev_b32 v32, 16, v36
v_and_b32 v33, 0xffff0000, v36
v_lshlrev_b32 v40, 16, v14
v_and_b32 v41, 0xffff0000, v14
v_lshlrev_b32 v34, 16, v37
v_and_b32 v35, 0xffff0000, v37
v_lshlrev_b32 v42, 16, v15
v_and_b32 v43, 0xffff0000, v15
v_add_f32 v32, v32, v40
v_add_f32 v33, v33, v41
v_add_f32 v34, v34, v42
v_add_f32 v35, v35, v43
v_cvt_pk_bf16_f32 v36, v32, v33
v_cvt_pk_bf16_f32 v37, v34, v35
v_lshlrev_b32 v32, 16, v36
v_and_b32 v33, 0xffff0000, v36
v_lshlrev_b32 v34, 16, v37
v_and_b32 v35, 0xffff0000, v37
v_mov_b32 v44, 0xc0135761
v_mul_f32 v36, v32, v32
v_mul_f32 v37, v33, v33
v_mul_f32 v38, v34, v34
v_mul_f32 v39, v35, v35
v_fmamk_f32 v36, v36, 0xbdd2d3e8, v44
v_fmamk_f32 v37, v37, 0xbdd2d3e8, v44
v_fmamk_f32 v38, v38, 0xbdd2d3e8, v44
v_fmamk_f32 v39, v39, 0xbdd2d3e8, v44
v_mul_f32 v36, v36, v32
v_mul_f32 v37, v37, v33
v_mul_f32 v38, v38, v34
v_mul_f32 v39, v39, v35
v_exp_f32 v36, v36
v_exp_f32 v37, v37
v_exp_f32 v38, v38
v_exp_f32 v39, v39
v_add_f32 v36, 1.0, v36
v_add_f32 v37, 1.0, v37
v_add_f32 v38, 1.0, v38
v_add_f32 v39, 1.0, v39
v_rcp_f32 v36, v36
v_rcp_f32 v37, v37
v_rcp_f32 v38, v38
v_rcp_f32 v39, v39
v_mul_f32 v32, v32, v36
v_mul_f32 v33, v33, v37
v_mul_f32 v34, v34, v38
v_mul_f32 v35, v35, v39
v_cvt_pk_bf16_f32 v40, v32, v33
v_cvt_pk_bf16_f32 v41, v34, v35
ds_write_b64 v11, v[40:41]
ds_read_b128 v[48:51], v12
ds_read_b128 v[52:55], v12 offset:64
s_add_u32 s10, s6, 2
s_and_b32 s10, s10, 7
s_lshl_b32 s10, s10, 5
s_add_u32 s10, s10, s15
s_lshl_b32 s10, s10, 10
s_add_u32 s10, s10, 1069056
v_lshlrev_b32 v10, 4, v1
v_mov_b32 v23, s44
s_branch W_16
W_15:
s_sleep 1
W_16:
ds_read_b32 v9, v8 offset:4
s_sub_u32 s46, s46, 1
s_cbranch_scc1 L_end
s_waitcnt lgkmcnt(0)
v_cmp_gt_u32 vcc, 10, v9
s_cbranch_vccnz W_15
ds_read_b64_tr_b16 v[64:65], v28 offset:0
ds_read_b64_tr_b16 v[66:67], v28 offset:2048
ds_read_b64_tr_b16 v[68:69], v29 offset:0
ds_read_b64_tr_b16 v[70:71], v29 offset:2048
ds_read_b64_tr_b16 v[72:73], v30 offset:0
ds_read_b64_tr_b16 v[74:75], v30 offset:2048
ds_read_b64_tr_b16 v[76:77], v31 offset:0
ds_read_b64_tr_b16 v[78:79], v31 offset:2048
ds_read_b64_tr_b16 v[80:81], v28 offset:4096
ds_read_b64_tr_b16 v[82:83], v28 offset:6144
ds_read_b64_tr_b16 v[84:85], v29 offset:4096
ds_read_b64_tr_b16 v[86:87], v29 offset:6144
ds_read_b64_tr_b16 v[88:89], v30 offset:4096
ds_read_b64_tr_b16 v[90:91], v30 offset:6144
ds_read_b64_tr_b16 v[92:93], v31 offset:4096
ds_read_b64_tr_b16 v[94:95], v31 offset:6144
s_waitcnt lgkmcnt(0)
v_mfma_f32_16x16x32_bf16 v[32:35], v[48:51], v[64:67], 0
v_mfma_f32_16x16x32_bf16 v[36:39], v[48:51], v[68:71], 0
v_mfma_f32_16x16x32_bf16 v[40:43], v[48:51], v[72:75], 0
v_mfma_f32_16x16x32_bf16 v[44:47], v[48:51], v[76:79], 0
v_mfma_f32_16x16x32_bf16 v[32:35], v[52:55], v[80:83], v[32:35]
v_mfma_f32_16x16x32_bf16 v[36:39], v[52:55], v[84:87], v[36:39]
v_mfma_f32_16x16x32_bf16 v[40:43], v[52:55], v[88:91], v[40:43]
v_mfma_f32_16x16x32_bf16 v[44:47], v[52:55], v[92:95], v[44:47]
s_nop 7
v_perm_b32 v20, v32, v44, s50
v_perm_b32 v21, v36, v44, s51
v_perm_b32 v22, v40, v44, s52
buffer_store_dwordx4 v[20:23], v10, s[40:43], s10 offen sc1
L_end:
L_exit:
s_endpgm

.section .rodata,"a"
.p2align 6
.amdhsa_kernel recurrent_scan__sliding_block_cached__mixer_channel_mlp__decode_kernel
  .amdhsa_next_free_vgpr 192
  .amdhsa_next_free_sgpr 102
  .amdhsa_accum_offset 192
  .amdhsa_group_segment_fixed_size 0
  .amdhsa_kernarg_size 104
  .amdhsa_user_sgpr_count 2
  .amdhsa_user_sgpr_kernarg_segment_ptr 1
  .amdhsa_system_sgpr_workgroup_id_x 1
  .amdhsa_float_denorm_mode_32 3
  .amdhsa_float_denorm_mode_16_64 3
.end_amdhsa_kernel
```
